```python
import torch

def _softmax(x, axis=-1):
    return torch.softmax(x, dim=axis)
def _gelu(x):
    return torch.nn.functional.gelu(x, approximate="tanh")
def _silu(x):
    return torch.nn.functional.silu(x)
def _sigmoid(x):
    return torch.sigmoid(x)
def _layernorm(x, axis=-1, eps=1e-5):
    m = x.mean(dim=axis, keepdim=True)
    v = x.var(dim=axis, keepdim=True, unbiased=False)
    return (x - m) / torch.sqrt(v + eps)
def _scatter_add(tgt, idx, src, axis=0):
    return tgt.clone().index_add_(axis, idx, src)
def _segment_sum(src, seg, n):
    out = torch.zeros((n,) + src.shape[1:], dtype=src.dtype)
    return out.index_add_(0, seg, src)
def _pad(x, pw):
    flat = tuple(v for pair in reversed(pw) for v in pair)
    return torch.nn.functional.pad(x, flat)

kernel_name = 'parallel_sum__sliding_block_cached__geglu_ffn__decode'

def setup_inputs():

    _w = (lambda a: (lambda t: t.to(torch.bfloat16) if t.is_floating_point() else t)(torch.as_tensor(a)))
    def _A_setup():
        B, Sq, D = 1, 1, 512
        Hq, Hkv, Sk, Dh = 32, 8, 65536, 128
        assert Hq % Hkv == 0, (Hq, Hkv)
        return {
            "x": _w((lambda *s: torch.randn(*s, dtype=torch.bfloat16) * 0.05)(B, Sq, D)),
            "k_cache": _w((lambda *s: torch.randn(*s, dtype=torch.bfloat16) * 3.2)(B, Hkv, Sk, Dh)),
            "v_cache": _w((lambda *s: torch.randn(*s, dtype=torch.bfloat16) * 1.6)(B, Hkv, Sk, Dh)),
            "wq": _w((lambda *s: torch.randn(*s, dtype=torch.bfloat16) * 3.2)(D, Hq * Dh) * (D ** -0.5)),
            "wo": _w((lambda *s: torch.randn(*s, dtype=torch.bfloat16) * 1.6)(Hq * Dh, D) * ((Hq * Dh) ** -0.5)),
        }
    _A_in = _A_setup()

    def _B_setup():
        B, S, D, F = 1, 1, 512, 1792
        return {
            "x": _w((lambda *s: torch.randn(*s, dtype=torch.bfloat16) * 0.05)(B, S, D)),
            "w_gate": _w((lambda *s: torch.randn(*s, dtype=torch.bfloat16) * 0.05)(D, F)),
            "w_up": _w((lambda *s: torch.randn(*s, dtype=torch.bfloat16) * 0.05)(D, F)),
            "w_down": _w((lambda *s: torch.randn(*s, dtype=torch.bfloat16) * 0.05)(F, D)),
        }
    _B_in = _B_setup()

    return {
        "A_x": _A_in["x"],
        "A_k_cache": _A_in["k_cache"],
        "A_v_cache": _A_in["v_cache"],
        "A_wq": _A_in["wq"],
        "A_wo": _A_in["wo"],
        "B_x": _B_in["x"],
        "B_w_gate": _B_in["w_gate"],
        "B_w_up": _B_in["w_up"],
        "B_w_down": _B_in["w_down"],
    }

def reference(A_x, A_k_cache, A_v_cache, A_wq, A_wo, B_x, B_w_gate, B_w_up, B_w_down):
    def _A_ref(x, k_cache, v_cache, wq, wo):
        B, Sq, D = x.shape
        Hq, Dh = 32, 128
        Hkv, Sk = k_cache.shape[1], k_cache.shape[2]
        W = min(4096, max(256, Sk // 4))
        rep = Hq // Hkv
        q = (lambda x, *d: x.permute(*d))((x @ wq).reshape(B, Sq, Hq, Dh), 0, 2, 1, 3)
        k = (lambda x, n, axis: torch.repeat_interleave(x, n, dim=axis))(k_cache[:, :, Sk - W:, :], rep, axis=1)
        v = (lambda x, n, axis: torch.repeat_interleave(x, n, dim=axis))(v_cache[:, :, Sk - W:, :], rep, axis=1)
        scores = torch.einsum("bhqd,bhkd->bhqk", q, k) * (Dh ** -0.5)
        p = _softmax(scores, axis=-1)
        o = torch.einsum("bhqk,bhkd->bhqd", p, v)
        return (lambda x, *d: x.permute(*d))(o, 0, 2, 1, 3).reshape(B, Sq, Hq * Dh) @ wo

    def _B_ref(x, w_gate, w_up, w_down):
        return (_gelu(x @ w_gate) * (x @ w_up)) @ w_down

    x = A_x
    xn = _layernorm(x, axis=-1)
    return x + _A_ref(xn, A_k_cache, A_v_cache, A_wq, A_wo) + _B_ref(xn, B_w_gate, B_w_up, B_w_down)
```

```asm
; @launch grid=(256,1,1) block=(512,1,1) lds=98304
.amdgcn_target "amdgcn-amd-amdhsa--gfx950"
.text
.globl parallel_sum__sliding_block_cached__geglu_ffn__decode_kernel
.p2align 8
.type parallel_sum__sliding_block_cached__geglu_ffn__decode_kernel,@function
parallel_sum__sliding_block_cached__geglu_ffn__decode_kernel:
    s_load_dwordx16 s[4:19], s[0:1], 0
    s_load_dwordx8 s[20:27], s[0:1], 64
    s_cmp_ge_u32 s2, 256
    s_cbranch_scc1 L_end
    v_lshrrev_b32 v2, 6, v0
    v_and_b32 v1, 63, v0
    v_readfirstlane_b32 s62, v2
    s_and_b32 s28, s2, 7
    s_lshr_b32 s29, s2, 3
    s_lshl_b32 s30, s28, 5
    s_add_u32 s30, s30, s29
    v_lshlrev_b32 v2, 4, v1
    v_lshrrev_b32 v12, 3, v1
    v_and_b32 v13, 0x70, v2
    v_and_b32 v9, 15, v1
    v_lshrrev_b32 v10, 4, v1
    s_and_b32 s3, s62, 3
    s_cmp_ge_u32 s62, 4
    s_cbranch_scc1 L_A1
    s_and_b32 s31, s29, 3
    s_lshl_b32 s31, s31, 2
    s_add_u32 s31, s31, s3
    s_lshl_b32 s31, s31, 18
    s_lshr_b32 s32, s30, 2
    s_lshl_b32 s32, s32, 7
    s_add_u32 s31, s31, s32
    v_and_b32 v43, 16, v1
    v_lshlrev_b32 v43, 1, v43
    v_xor_b32 v43, v43, v13
    v_lshl_add_u32 v3, v12, 13, v43
    v_add_u32 v3, s31, v3
    v_xor_b32 v4, 0x10040, v3
    v_add_u32 v7, 0x20000, v3
    v_xor_b32 v6, 0x30040, v3
    s_lshl_b32 m0, s3, 12
    s_setprio 2
    s_waitcnt lgkmcnt(0)
    global_load_dwordx4 v[16:19], v2, s[4:5]
    global_load_lds_dwordx4 v3, s[10:11] nt
    s_add_u32 m0, m0, 1024
    s_nop 0
    global_load_lds_dwordx4 v4, s[10:11] nt
    s_add_u32 m0, m0, 1024
    s_nop 0
    global_load_lds_dwordx4 v7, s[10:11] nt
    s_add_u32 m0, m0, 1024
    s_nop 0
    global_load_lds_dwordx4 v6, s[10:11] nt
    s_load_dword s36, s[26:27], 0
    s_barrier
    s_branch L_P2
L_A1:
    s_getpc_b64 s[34:35]
L_pc:
    s_lshl_b32 s31, s29, 2
    s_add_u32 s31, s31, s3
    s_lshl_b32 s31, s31, 7
    s_min_u32 s31, s31, L_end-L_pc
    v_mov_b32 v14, s31
    s_mov_b64 exec, 1
    global_load_dword v126, v14, s[34:35]
    s_mov_b64 exec, -1
    v_lshlrev_b32 v14, 2, v1
    v_mov_b32 v15, -1
    ds_write_b32 v14, v15 offset:58368
    ds_write_b32 v14, v15 offset:58432
    s_lshl_b32 s31, s3, 13
    s_lshl_b32 s32, s29, 15
    s_add_u32 s31, s31, s32
    s_xor_b32 s33, s29, s28
    s_and_b32 s33, s33, 7
    s_lshl_b32 s33, s33, 12
    s_xor_b32 s31, s31, s33
    s_lshl_b32 s32, s28, 24
    s_add_u32 s31, s31, s32
    s_add_u32 s31, s31, 15728640
    v_and_b32 v7, 3, v9
    v_lshlrev_b32 v7, 8, v7
    v_lshrrev_b32 v8, 2, v9
    v_lshl_add_u32 v7, v8, 10, v7
    v_lshl_add_u32 v7, v10, 4, v7
    v_add_u32 v7, s31, v7
    v_xor_b32 v26, 4096, v7
    v_lshlrev_b32 v8, 10, v10
    v_lshl_add_u32 v8, v9, 4, v8
    v_add_u32 v8, s31, v8
    s_setprio 1
    s_waitcnt lgkmcnt(0)
    s_load_dword s36, s[26:27], 0
    s_barrier
    s_getreg_b32 s55, hwreg(HW_REG_XCC_ID, 0, 4)
    s_add_u32 s56, s26, 1048576
    s_addc_u32 s57, s27, 0
    s_mov_b64 s[58:59], s[26:27]
    s_mov_b32 s54, 0
    s_lshr_b32 s31, s29, 3
    s_lshl_b32 s52, s28, 2
    s_add_u32 s52, s52, s31
    s_mov_b32 s38, 0x07060500
    s_mov_b32 s39, 0x07060501
    s_mov_b32 s40, 0x07060502
    s_mov_b32 s41, 0x07060503
    s_movk_i32 s44, 0xff
    s_lshl_b32 s31, s3, 2
    v_mov_b32 v42, s31
    v_mov_b32 v40, 0
    s_lshl_b32 s61, s28, 13
    s_add_u32 s61, s61, 4096
    s_and_b32 s31, s29, 3
    s_lshl_b32 s31, s31, 11
    s_add_u32 s31, s31, s61
    s_and_b32 s32, s29, 28
    s_add_u32 s32, s32, s3
    s_lshl_b32 s32, s32, 6
    s_add_u32 s31, s31, s32
    v_lshl_add_u32 v5, v10, 4, s31
    s_lshl_b32 s31, s30, 2
    s_add_u32 s31, s31, 2048
    v_mov_b32 v38, s31
    s_lshl_b32 s31, s3, 6
    v_lshl_add_u32 v41, v10, 4, s31
    s_lshl_b32 s31, s3, 9
    s_add_u32 s31, s31, s61
    s_add_u32 s31, s31, 4096
    v_and_b32 v14, 0x1f0, v2
    v_lshrrev_b32 v6, 5, v1
    v_lshl_add_u32 v6, v6, 11, v14
    v_add_u32 v6, s31, v6
    s_lshl_b32 s31, s28, 7
    s_add_u32 s31, s31, 2048
    v_lshrrev_b32 v14, 2, v14
    v_add_u32 v39, s31, v14
    global_load_dwordx4 v[128:131], v7, s[6:7] offset:0 nt
    global_load_dwordx4 v[132:135], v7, s[6:7] offset:64 nt
    global_load_dwordx4 v[136:139], v7, s[6:7] offset:128 nt
    global_load_dwordx4 v[140:143], v7, s[6:7] offset:192 nt
    global_load_dwordx4 v[144:147], v26, s[6:7] offset:0 nt
    global_load_dwordx4 v[148:151], v26, s[6:7] offset:64 nt
    s_branch L_A2
L_P2:
    s_getreg_b32 s55, hwreg(HW_REG_XCC_ID, 0, 4)
    s_add_u32 s56, s26, 1048576
    s_addc_u32 s57, s27, 0
    s_mov_b64 s[58:59], s[26:27]
    s_mov_b32 s54, 0
    s_lshr_b32 s31, s29, 3
    s_lshl_b32 s52, s28, 2
    s_add_u32 s52, s52, s31
    s_mov_b32 s38, 0x07060500
    s_mov_b32 s39, 0x07060501
    s_mov_b32 s40, 0x07060502
    s_mov_b32 s41, 0x07060503
    s_movk_i32 s44, 0xff
    s_lshl_b32 s31, s3, 2
    v_mov_b32 v42, s31
    v_mov_b32 v40, 0
    s_lshl_b32 s61, s28, 13
    s_add_u32 s61, s61, 4096
    s_and_b32 s31, s29, 3
    s_lshl_b32 s31, s31, 11
    s_add_u32 s31, s31, s61
    s_and_b32 s32, s29, 28
    s_add_u32 s32, s32, s3
    s_lshl_b32 s32, s32, 6
    s_add_u32 s31, s31, s32
    v_lshl_add_u32 v5, v10, 4, s31
    s_lshl_b32 s31, s30, 2
    s_add_u32 s31, s31, 2048
    v_mov_b32 v38, s31
    s_lshl_b32 s31, s3, 6
    v_lshl_add_u32 v41, v10, 4, s31
    s_and_b32 s33, s29, 7
    s_lshl_b32 s31, s33, 2
    s_add_u32 s31, s31, s3
    s_lshl_b32 s31, s31, 11
    s_lshl_b32 s32, s52, 6
    s_add_u32 s31, s31, s32
    s_add_u32 s31, s31, 851968
    v_lshl_add_u32 v39, v10, 4, s31
    s_lshl_b32 s31, s30, 11
    s_add_u32 s31, s31, 327680
    s_mov_b32 s32, 15
    s_lshl_b32 s48, s30, 9
    s_add_u32 s48, s48, 69632
    s_cmp_eq_u32 s3, 1
    s_cselect_b32 s31, s48, s31
    s_cselect_b32 s32, 3, s32
    s_lshl_b32 s48, s30, 8
    s_add_u32 s48, s48, 4096
    s_cmp_eq_u32 s3, 2
    s_cselect_b32 s31, s48, s31
    s_cselect_b32 s32, 1, s32
    s_lshl_b32 s48, s30, 5
    s_add_u32 s48, s48, 200704
    s_cmp_eq_u32 s3, 3
    s_cselect_b32 s31, s48, s31
    s_cselect_b32 s32, 0, s32
    v_and_b32 v44, s32, v1
    v_lshl_add_u32 v44, v44, 7, s31
    v_cmp_gt_u32 vcc, 16, v1
    v_cmp_gt_u32 s[50:51], 32, v1
    s_nop 0
    v_cndmask_b32 v44, v38, v44, vcc
    v_cndmask_b32 v44, v39, v44, s[50:51]
    global_load_dword v126, v44, s[26:27]
    s_and_b32 s53, s29, 24
    s_add_u32 s53, s53, s28
    s_lshl_b32 s32, s33, 2
    s_add_u32 s32, s32, s3
    s_mul_i32 s32, s32, 57344
    s_lshl_b32 s31, s53, 7
    s_add_u32 s32, s32, s31
    v_mul_u32_u24 v11, 3584, v12
    v_add3_u32 v11, v11, v43, s32
    v_add_u32 v14, 28672, v11
    v_xor_b32 v14, 64, v14
    v_lshl_add_u32 v37, v12, 10, v43
    s_lshl_b32 s31, s52, 2
    s_add_u32 s31, s31, s3
    s_lshl_b32 s31, s31, 15
    s_lshl_b32 s32, s33, 7
    s_add_u32 s31, s31, s32
    v_add_u32 v36, s31, v37
    s_lshl_b32 s31, s53, 2
    s_add_u32 s31, s31, s3
    s_lshl_b32 s31, s31, 14
    s_add_u32 s31, s31, s32
    v_add_u32 v37, s31, v37
    v_bfe_u32 v3, v1, 2, 2
    v_lshl_add_u32 v3, v10, 3, v3
    v_lshlrev_b32 v3, 7, v3
    v_and_b32 v4, 3, v1
    v_lshl_add_u32 v3, v4, 3, v3
    s_lshl_b32 s31, s3, 5
    v_add_u32 v3, s31, v3
    v_bfe_u32 v4, v1, 3, 2
    v_lshlrev_b32 v4, 5, v4
    v_xor_b32 v3, v3, v4
    s_and_b32 s31, s29, 3
    s_lshl_b32 s31, s31, 8
    v_lshl_add_u32 v4, v10, 4, s31
    s_lshl_b32 s31, s33, 7
    v_lshl_add_u32 v6, v10, 4, s31
    s_lshl_b32 s49, s3, 11
    s_waitcnt vmcnt(5)
    v_lshlrev_b32 v20, 16, v16
    v_and_b32 v21, 0xffff0000, v16
    v_lshlrev_b32 v22, 16, v17
    v_and_b32 v23, 0xffff0000, v17
    v_lshlrev_b32 v24, 16, v18
    v_and_b32 v25, 0xffff0000, v18
    v_lshlrev_b32 v26, 16, v19
    v_and_b32 v27, 0xffff0000, v19
    v_readfirstlane_b32 s50, v20
    s_nop 1
    v_pk_add_f32 v[48:49], v[20:21], s[50:51] op_sel_hi:[1,0] neg_lo:[0,1] neg_hi:[0,1]
    v_pk_add_f32 v[50:51], v[22:23], s[50:51] op_sel_hi:[1,0] neg_lo:[0,1] neg_hi:[0,1]
    v_pk_add_f32 v[52:53], v[24:25], s[50:51] op_sel_hi:[1,0] neg_lo:[0,1] neg_hi:[0,1]
    v_pk_add_f32 v[54:55], v[26:27], s[50:51] op_sel_hi:[1,0] neg_lo:[0,1] neg_hi:[0,1]
    v_pk_mul_f32 v[30:31], v[48:49], v[48:49]
    v_pk_add_f32 v[28:29], v[48:49], v[50:51]
    v_pk_fma_f32 v[30:31], v[50:51], v[50:51], v[30:31]
    v_pk_add_f32 v[28:29], v[28:29], v[52:53]
    v_pk_fma_f32 v[30:31], v[52:53], v[52:53], v[30:31]
    v_pk_add_f32 v[28:29], v[28:29], v[54:55]
    v_pk_fma_f32 v[30:31], v[54:55], v[54:55], v[30:31]
    v_add_f32 v28, v28, v29
    v_add_f32 v29, v30, v31
    s_nop 0
    v_add_f32_dpp v28, v28, v28 row_ror:1 row_mask:0xf bank_mask:0xf
    v_add_f32_dpp v29, v29, v29 row_ror:1 row_mask:0xf bank_mask:0xf
    s_nop 0
    v_add_f32_dpp v28, v28, v28 row_ror:2 row_mask:0xf bank_mask:0xf
    v_add_f32_dpp v29, v29, v29 row_ror:2 row_mask:0xf bank_mask:0xf
    s_nop 0
    v_add_f32_dpp v28, v28, v28 row_ror:4 row_mask:0xf bank_mask:0xf
    v_add_f32_dpp v29, v29, v29 row_ror:4 row_mask:0xf bank_mask:0xf
    s_nop 0
    v_add_f32_dpp v28, v28, v28 row_ror:8 row_mask:0xf bank_mask:0xf
    v_add_f32_dpp v29, v29, v29 row_ror:8 row_mask:0xf bank_mask:0xf
    s_nop 0
    s_nop 0
    v_permlane32_swap_b32 v28, v29
    v_add_f32 v28, v28, v29
    v_mov_b32 v29, v28
    s_nop 1
    v_permlane16_swap_b32 v28, v29
    v_add_f32 v28, v28, v29
    v_mul_f32 v28, 0x3b000000, v28
    s_nop 0
    v_readlane_b32 s32, v28, 0
    v_readlane_b32 s48, v28, 32
    s_nop 0
    v_mov_b32 v28, s32
    v_fma_f32 v29, -v28, v28, s48
    v_add_f32 v28, s50, v28
    v_max_f32 v29, 0, v29
    v_cvt_pk_bf16_f32 v28, 0, v28
    v_cvt_pk_bf16_f32 v29, 0, v29
    v_add_f32 v29, 0x3727c5ac, v29
    v_cvt_pk_bf16_f32 v29, 0, v29
    v_sqrt_f32 v31, v29
    v_pk_add_f32 v[20:21], v[20:21], v[28:29] op_sel_hi:[1,0] neg_lo:[0,1] neg_hi:[0,1]
    v_pk_add_f32 v[22:23], v[22:23], v[28:29] op_sel_hi:[1,0] neg_lo:[0,1] neg_hi:[0,1]
    v_pk_add_f32 v[24:25], v[24:25], v[28:29] op_sel_hi:[1,0] neg_lo:[0,1] neg_hi:[0,1]
    v_pk_add_f32 v[26:27], v[26:27], v[28:29] op_sel_hi:[1,0] neg_lo:[0,1] neg_hi:[0,1]
    v_cvt_pk_bf16_f32 v29, 0, v31
    v_rcp_f32 v30, v29
    v_cvt_pk_bf16_f32 v20, 0, v20
    v_cvt_pk_bf16_f32 v21, 0, v21
    v_cvt_pk_bf16_f32 v22, 0, v22
    v_cvt_pk_bf16_f32 v23, 0, v23
    v_cvt_pk_bf16_f32 v24, 0, v24
    v_cvt_pk_bf16_f32 v25, 0, v25
    v_cvt_pk_bf16_f32 v26, 0, v26
    v_cvt_pk_bf16_f32 v27, 0, v27
    v_pk_mul_f32 v[20:21], v[20:21], v[30:31] op_sel:[0,0] op_sel_hi:[1,0]
    v_pk_mul_f32 v[22:23], v[22:23], v[30:31] op_sel:[0,0] op_sel_hi:[1,0]
    v_pk_mul_f32 v[24:25], v[24:25], v[30:31] op_sel:[0,0] op_sel_hi:[1,0]
    v_pk_mul_f32 v[26:27], v[26:27], v[30:31] op_sel:[0,0] op_sel_hi:[1,0]
    v_cvt_pk_bf16_f32 v16, v20, v21
    v_cvt_pk_bf16_f32 v17, v22, v23
    v_cvt_pk_bf16_f32 v18, v24, v25
    v_cvt_pk_bf16_f32 v19, v26, v27
    ds_write_b128 v2, v[16:19] offset:57344
    ds_read_b128 v[20:23], v4 offset:57344
    ds_read_b128 v[24:27], v4 offset:57408
    ds_read_b128 v[28:31], v4 offset:57472
    ds_read_b128 v[32:35], v4 offset:57536
    ds_read_b128 v[48:51], v6 offset:57344
    ds_read_b128 v[52:55], v6 offset:57408
    s_waitcnt vmcnt(1)
    ds_write_b32 v42, v40 offset:58496
    s_waitcnt lgkmcnt(0)
    s_mul_i32 s36, s36, 0x9E3779B1
    s_add_u32 s36, s36, 0x7F4A7C15
    s_add_u32 s55, s55, 1
    s_mul_i32 s55, s55, 0x85EBCA6B
    s_xor_b32 s55, s55, s36
    s_mov_b32 s60, s55
    v_mov_b32 v124, s55
    v_mov_b32 v125, s36
    s_bfe_u32 s98, s55, 0x00080000
    s_bfe_u32 s99, s55, 0x00080008
    s_bfe_u32 s100, s55, 0x00080010
    s_bfe_u32 s101, s55, 0x00080018
L_ps6:
    ds_read_b128 v[44:47], v40 offset:58496
    ds_read_b64_tr_b16 v[64:65], v3 offset:0
    ds_read_b64_tr_b16 v[66:67], v3 offset:512
    ds_read_b64_tr_b16 v[68:69], v3 offset:4096
    ds_read_b64_tr_b16 v[70:71], v3 offset:4608
    ds_read_b64_tr_b16 v[72:73], v3 offset:8192
    ds_read_b64_tr_b16 v[74:75], v3 offset:8704
    ds_read_b64_tr_b16 v[76:77], v3 offset:12288
    ds_read_b64_tr_b16 v[78:79], v3 offset:12800
    s_waitcnt lgkmcnt(8)
    v_or3_b32 v44, v44, v45, v46
    v_or_b32 v44, v44, v47
    v_cmp_ne_u32 vcc, 0, v44
    s_cbranch_vccnz L_ps6
    s_waitcnt lgkmcnt(6)
    v_mfma_f32_16x16x32_bf16 v[88:91], v[64:67], v[20:23], 0
    s_waitcnt lgkmcnt(4)
    v_mfma_f32_16x16x32_bf16 v[88:91], v[68:71], v[24:27], v[88:91]
    s_waitcnt lgkmcnt(2)
    v_mfma_f32_16x16x32_bf16 v[88:91], v[72:75], v[28:31], v[88:91]
    s_waitcnt lgkmcnt(0)
    v_mfma_f32_16x16x32_bf16 v[88:91], v[76:79], v[32:35], v[88:91]
    s_mov_b32 exec_lo, 0x00010001
    s_mov_b32 exec_hi, 0x00010001
    global_store_dword v38, v124, s[26:27]
    s_nop 4
    v_add_u32 v88, 0x80, v88
    v_add_u32 v89, 0x80, v89
    v_add_u32 v90, 0x80, v90
    v_add_u32 v91, 0x80, v91
    v_perm_b32 v88, v88, v124, s38
    v_perm_b32 v89, v89, v124, s39
    v_perm_b32 v90, v90, v124, s40
    v_perm_b32 v91, v91, v124, s41
    global_store_dwordx4 v5, v[88:91], s[26:27]
    ds_write_b128 v41, v[88:91] offset:59072
    s_mov_b64 exec, -1
    ds_write_b32 v42, v40 offset:58560
    s_lshl_b32 s31, s30, 2
    s_add_u32 s31, s31, s3
    s_lshl_b32 s31, s31, 7
    s_add_u32 s31, s31, 69632
    v_and_b32 v18, 1, v1
    v_lshlrev_b32 v18, 6, v18
    v_lshl_add_u32 v18, v10, 4, v18
    v_add_u32 v18, s31, v18
    s_and_b32 s31, s31, 0xfffff1ff
    v_lshl_add_u32 v5, v12, 9, v13
    v_add_u32 v5, s31, v5
    s_mov_b32 s50, 0x00020002
    s_mov_b32 s51, 0x00020002
    v_and_b32 v15, 3, v1
    v_lshlrev_b32 v15, 3, v15
    v_lshl_add_u32 v15, v10, 1, v15
    s_lshl_b32 s31, s2, 5
    v_add_u32 v17, s31, v15
    s_lshl_b32 s31, s3, 5
    v_add_u32 v15, s31, v15
    v_lshlrev_b32 v4, 4, v10
    s_and_b32 s31, s2, 0
    s_add_u32 s31, s31, s2
    s_lshl_b32 s31, s31, 11
    s_add_u32 s31, s31, 851968
    v_add_u32 v13, s31, v2
    s_mov_b32 s47, 2000000
    s_lshl_b32 s46, s3, 12
    s_cmp_ge_u32 s53, 28
    s_cbranch_scc1 L_noffn
    s_setprio 0
L_ps7:
    ds_read_b128 v[44:47], v40 offset:58544
    s_waitcnt lgkmcnt(0)
    v_or3_b32 v44, v44, v45, v46
    v_or_b32 v44, v44, v47
    v_cmp_ne_u32 vcc, 0, v44
    s_cbranch_vccnz L_ps7
    s_add_u32 m0, s49, 16384
    s_nop 0
    global_load_lds_dwordx4 v11, s[16:17] nt
    s_add_u32 m0, s49, 24576
    s_nop 0
    global_load_lds_dwordx4 v11, s[18:19] nt
    s_add_u32 m0, s49, 17408
    s_nop 0
    global_load_lds_dwordx4 v14, s[16:17] nt
    s_add_u32 m0, s49, 25600
    s_nop 0
    global_load_lds_dwordx4 v14, s[18:19] nt
    s_add_u32 m0, s49, 49152
    s_nop 0
    global_load_lds_dwordx4 v37, s[20:21] nt
    v_xor_b32 v37, 0x2040, v37
    s_add_u32 m0, s49, 50176
    s_nop 0
    global_load_lds_dwordx4 v37, s[20:21] nt
L_ps8:
    ds_read_b128 v[44:47], v40 offset:58656
    s_waitcnt lgkmcnt(0)
    v_or3_b32 v44, v44, v45, v46
    v_or_b32 v44, v44, v47
    v_cmp_ne_u32 vcc, 0, v44
    s_cbranch_vccnz L_ps8
    s_add_u32 m0, s46, 32768
    s_nop 0
    global_load_lds_dwordx4 v36, s[12:13] nt
    v_xor_b32 v36, 0x00002040, v36
    s_add_u32 m0, s46, 33792
    s_nop 0
    global_load_lds_dwordx4 v36, s[12:13] nt
    v_xor_b32 v36, 0x00006040, v36
    s_add_u32 m0, s46, 34816
    s_nop 0
    global_load_lds_dwordx4 v36, s[12:13] nt
    v_xor_b32 v36, 0x00002040, v36
    s_add_u32 m0, s46, 35840
    s_nop 0
    global_load_lds_dwordx4 v36, s[12:13] nt
    s_waitcnt vmcnt(6)
    ds_write_b32 v42, v40 offset:58512
L_ps9:
    ds_read_b128 v[44:47], v40 offset:58512
    ds_read_b64_tr_b16 v[64:65], v3 offset:16384
    ds_read_b64_tr_b16 v[66:67], v3 offset:16896
    ds_read_b64_tr_b16 v[68:69], v3 offset:20480
    ds_read_b64_tr_b16 v[70:71], v3 offset:20992
    ds_read_b64_tr_b16 v[72:73], v3 offset:24576
    ds_read_b64_tr_b16 v[74:75], v3 offset:25088
    ds_read_b64_tr_b16 v[76:77], v3 offset:28672
    ds_read_b64_tr_b16 v[78:79], v3 offset:29184
    s_waitcnt lgkmcnt(8)
    v_or3_b32 v44, v44, v45, v46
    v_or_b32 v44, v44, v47
    v_cmp_ne_u32 vcc, 0, v44
    s_cbranch_vccnz L_ps9
    s_waitcnt lgkmcnt(6)
    v_mfma_f32_16x16x32_bf16 v[88:91], v[64:67], v[48:51], 0
    s_waitcnt lgkmcnt(4)
    v_mfma_f32_16x16x32_bf16 v[88:91], v[68:71], v[52:55], v[88:91]
    s_waitcnt lgkmcnt(2)
    v_mfma_f32_16x16x32_bf16 v[92:95], v[72:75], v[48:51], 0
    s_waitcnt lgkmcnt(0)
    v_mfma_f32_16x16x32_bf16 v[92:95], v[76:79], v[52:55], v[92:95]
    s_mov_b32 exec_lo, 0x00030003
    s_mov_b32 exec_hi, 0x00030003
    s_nop 5
    v_cndmask_b32 v88, v88, v92, s[50:51]
    v_cndmask_b32 v89, v89, v93, s[50:51]
    v_cndmask_b32 v90, v90, v94, s[50:51]
    v_cndmask_b32 v91, v91, v95, s[50:51]
    v_perm_b32 v88, v88, v124, s38
    v_perm_b32 v89, v89, v124, s39
    v_perm_b32 v90, v90, v124, s40
    v_perm_b32 v91, v91, v124, s41
    global_store_dwordx4 v18, v[88:91], s[26:27]
    s_mov_b64 exec, -1
    ds_write_b32 v42, v40 offset:58640
    s_waitcnt vmcnt(0)
    global_load_dwordx4 v[56:59], v5, s[58:59] sc1
    ds_write_b32 v42, v40 offset:58592
L_ps10:
    ds_read_b128 v[44:47], v40 offset:58592
    ds_read_b64_tr_b16 v[64:65], v3 offset:32768
    ds_read_b64_tr_b16 v[66:67], v3 offset:33280
    ds_read_b64_tr_b16 v[68:69], v3 offset:36864
    ds_read_b64_tr_b16 v[70:71], v3 offset:37376
    ds_read_b64_tr_b16 v[72:73], v3 offset:40960
    ds_read_b64_tr_b16 v[74:75], v3 offset:41472
    ds_read_b64_tr_b16 v[76:77], v3 offset:45056
    ds_read_b64_tr_b16 v[78:79], v3 offset:45568
    ds_read_b64_tr_b16 v[80:81], v3 offset:49152
    ds_read_b64_tr_b16 v[82:83], v3 offset:49664
    ds_read_b64_tr_b16 v[84:85], v3 offset:53248
    ds_read_b64_tr_b16 v[86:87], v3 offset:53760
    s_waitcnt lgkmcnt(12)
    v_or3_b32 v44, v44, v45, v46
    v_or_b32 v44, v44, v47
    v_cmp_ne_u32 vcc, 0, v44
    s_cbranch_vccnz L_ps10
    s_branch L_pg0
L_pg:
    global_load_dwordx4 v[56:59], v5, s[58:59] sc1
L_pg0:
    s_waitcnt vmcnt(0)
L_pg1:
    v_xor_b32 v56, s98, v56
    v_xor_b32 v57, s99, v57
    v_xor_b32 v58, s100, v58
    v_xor_b32 v59, s101, v59
    v_or3_b32 v63, v56, v57, v58
    v_bitop3_b32 v63, v63, v59, s44 bitop3:0xa8
    v_cmp_ne_u32 vcc, 0, v63
    s_cbranch_vccnz L_pg_retry
L_pg_ok:
    s_mov_b64 exec, -1
    v_permlane32_swap_b32 v56, v58
    v_permlane32_swap_b32 v57, v59
    v_pk_add_f32 v[56:57], v[56:57], v[58:59]
    s_nop 1
    v_permlane16_swap_b32 v56, v57
    v_add_f32 v56, v56, v57
    s_nop 1
    v_add_f32_dpp v56, v56, v56 row_ror:8 row_mask:0xf bank_mask:0xf
    v_cvt_pk_bf16_f32 v56, 0, v56
    v_mul_f32 v57, v56, v56
    v_mul_f32 v57, 0x3d372713, v57
    v_mov_b32_dpp v58, v56 row_ror:4 row_mask:0xf bank_mask:0xf
    v_fma_f32 v57, v57, v56, v56
    v_mul_f32 v57, 0xc0135761, v57
    v_exp_f32 v57, v57
    s_nop 0
    v_add_f32 v57, 1.0, v57
    v_rcp_f32 v57, v57
    s_nop 0
    v_mul_f32 v56, v56, v57
    v_cvt_pk_bf16_f32 v56, 0, v56
    v_mul_f32 v56, v56, v58
    v_cvt_pk_bf16_f32 v56, v56, v56
    s_mov_b32 exec_lo, 0x000f000f
    s_mov_b32 exec_hi, 0x000f000f
    ds_write_b16 v15, v56 offset:58944
    s_mov_b64 exec, -1
    ds_write_b32 v42, v40 offset:58672
L_ps11:
    ds_read_b128 v[44:47], v40 offset:58672
    ds_read_b128 v[48:51], v4 offset:58944
    ds_read_b128 v[52:55], v4 offset:59008
    s_waitcnt lgkmcnt(2)
    v_or3_b32 v44, v44, v45, v46
    v_or_b32 v44, v44, v47
    v_cmp_ne_u32 vcc, 0, v44
    s_cbranch_vccnz L_ps11
    s_waitcnt lgkmcnt(0)
    v_mfma_f32_16x16x32_bf16 v[88:91], v[80:83], v[48:51], 0
    v_mfma_f32_16x16x32_bf16 v[88:91], v[84:87], v[52:55], v[88:91]
L_final:
    s_lshl_b32 s31, s3, 5
    s_add_u32 s31, s31, s2
    s_cmp_ge_u32 s31, 32
    s_cbranch_scc1 L_nr
    global_load_ushort v61, v17, s[4:5]
L_nr:
L_ps15:
    ds_read_b128 v[44:47], v40 offset:58608
    ds_read_b128 v[20:23], v4 offset:58688
    ds_read_b128 v[24:27], v4 offset:58752
    ds_read_b128 v[28:31], v4 offset:58816
    ds_read_b128 v[32:35], v4 offset:58880
    s_waitcnt lgkmcnt(4)
    v_or3_b32 v44, v44, v45, v46
    v_or_b32 v44, v44, v47
    v_cmp_ne_u32 vcc, 0, v44
    s_cbranch_vccnz L_ps15
    s_waitcnt lgkmcnt(3)
    v_mfma_f32_16x16x32_bf16 v[88:91], v[64:67], v[20:23], v[88:91]
    s_waitcnt lgkmcnt(2)
    v_mfma_f32_16x16x32_bf16 v[88:91], v[68:71], v[24:27], v[88:91]
    s_waitcnt lgkmcnt(1)
    v_mfma_f32_16x16x32_bf16 v[88:91], v[72:75], v[28:31], v[88:91]
    s_waitcnt lgkmcnt(0)
    v_mfma_f32_16x16x32_bf16 v[88:91], v[76:79], v[32:35], v[88:91]
    s_mov_b32 exec_lo, 0x00010001
    s_mov_b32 exec_hi, 0x00010001
    s_nop 5
    v_perm_b32 v88, v88, v125, s38
    v_perm_b32 v89, v89, v125, s39
    v_perm_b32 v90, v90, v125, s40
    v_perm_b32 v91, v91, v125, s41
    global_store_dwordx4 v39, v[88:91], s[26:27] sc1
    s_mov_b64 exec, -1
    s_cmp_ge_u32 s2, 32
    s_cbranch_scc1 L_fin
    s_cmp_lg_u32 s3, 0
    s_cbranch_scc1 L_fin
    s_mov_b32 s47, 2000000
    s_bfe_u32 s98, s36, 0x80000
    s_bfe_u32 s99, s36, 0x80008
    s_bfe_u32 s100, s36, 0x80010
    s_bfe_u32 s101, s36, 0x80018
L_py:
    global_load_dwordx4 v[48:51], v13, s[26:27] sc1
    global_load_dwordx4 v[52:55], v13, s[26:27] offset:1024 sc1
    s_waitcnt vmcnt(0)
    v_xor_b32 v48, s98, v48
    v_xor_b32 v49, s99, v49
    v_xor_b32 v50, s100, v50
    v_xor_b32 v51, s101, v51
    v_xor_b32 v52, s98, v52
    v_xor_b32 v53, s99, v53
    v_xor_b32 v54, s100, v54
    v_xor_b32 v55, s101, v55
    v_or3_b32 v59, v48, v49, v50
    v_or3_b32 v59, v59, v51, v52
    v_or3_b32 v59, v59, v53, v54
    v_bitop3_b32 v59, v59, v55, s44 bitop3:0xa8
    v_cmp_ne_u32 vcc, 0, v59
    s_cbranch_vccz L_py_ok
    s_mov_b64 exec, vcc
    s_sub_u32 s47, s47, 1
    s_cbranch_scc0 L_py
L_py_ok:
    s_mov_b64 exec, -1
    v_pk_add_f32 v[48:49], v[48:49], v[52:53]
    v_pk_add_f32 v[50:51], v[50:51], v[54:55]
    v_lshlrev_b32 v61, 16, v61
    s_nop 0
    v_permlane32_swap_b32 v48, v50
    v_permlane32_swap_b32 v49, v51
    v_pk_add_f32 v[48:49], v[48:49], v[50:51]
    s_nop 1
    v_permlane16_swap_b32 v48, v49
    v_add_f32 v48, v48, v49
    s_nop 1
    v_add_f32_dpp v48, v48, v48 row_ror:4 row_mask:0xf bank_mask:0xf
    s_nop 1
    v_add_f32_dpp v48, v48, v48 row_ror:8 row_mask:0xf bank_mask:0xf
    s_mov_b32 exec_lo, 0x000f000f
    s_mov_b32 exec_hi, 0x000f000f
    v_add_f32 v48, v48, v61
    v_cvt_pk_bf16_f32 v48, v48, v48
    global_store_short v17, v48, s[22:23]
    s_cmp_lg_u32 s2, 0
    s_cbranch_scc1 L_fin
    s_mov_b64 exec, 1
    global_store_dword v40, v125, s[26:27]
L_fin:
    s_endpgm
L_A2:
    v_mov_b32 v96, 0x3f803f80
    v_mov_b32 v97, 0x3f803f80
    v_mov_b32 v98, 0x3f803f80
    v_mov_b32 v99, 0x3f803f80
    v_bfe_u32 v14, v1, 2, 2
    v_cmp_eq_u32 s[50:51], 0, v14
    s_nop 1
    v_cndmask_b32 v104, 0, -1, s[50:51]
    v_cmp_eq_u32 s[50:51], 1, v14
    s_nop 1
    v_cndmask_b32 v105, 0, -1, s[50:51]
    v_cmp_eq_u32 s[50:51], 2, v14
    s_nop 1
    v_cndmask_b32 v106, 0, -1, s[50:51]
    v_cmp_eq_u32 s[50:51], 3, v14
    s_nop 1
    v_cndmask_b32 v107, 0, -1, s[50:51]
    s_mov_b32 s42, 0x05040100
    s_mov_b32 s43, 0x07060302
    s_mul_i32 s31, s3, 272
    s_add_u32 s31, s31, 59392
    v_and_b32 v24, 31, v1
    v_lshl_add_u32 v24, v24, 3, s31
    v_lshrrev_b32 v14, 5, v1
    v_lshl_add_u32 v24, v14, 2, v24
    v_and_b32 v17, 3, v1
    v_mul_u32_u24 v17, 272, v17
    v_lshl_add_u32 v14, v10, 4, v17
    s_mov_b32 s48, 0x3db504f3
    s_mov_b32 s49, 0x3fb8aa3b
    s_mul_i32 s31, s3, 2176
    v_mul_u32_u24 v15, 272, v10
    v_lshl_add_u32 v15, v9, 4, v15
    v_add_u32 v15, s31, v15
    v_add_u32 v16, v42, v2
    v_and_b32 v18, 12, v1
    v_add_u32 v18, v18, v10
    v_lshl_add_u32 v17, v18, 4, v17
    s_mul_i32 s31, s3, 1088
    v_add_u32 v17, s31, v17
    v_lshlrev_b32 v18, 4, v10
    s_lshl_b32 s31, s30, 3
    s_add_u32 s31, s31, s3
    s_lshl_b32 s31, s31, 8
    s_add_u32 s31, s31, 327680
    v_lshlrev_b32 v19, 9, v10
    v_lshl_add_u32 v19, v9, 4, v19
    v_add_u32 v19, s31, v19
    s_lshl_b32 s31, s28, 10
    s_lshl_b32 s32, s29, 3
    s_add_u32 s31, s31, s32
    s_add_u32 s31, s31, 200704
    v_lshl_add_u32 v20, v10, 8, s31
    s_lshl_b32 s31, s28, 16
    s_and_b32 s32, s29, 24
    s_lshl_b32 s32, s32, 6
    s_add_u32 s31, s31, s32
    s_lshl_b32 s32, s3, 7
    s_add_u32 s31, s31, s32
    s_add_u32 s31, s31, 331776
    v_lshl_add_u32 v43, v12, 13, v13
    v_add_u32 v43, s31, v43
    s_lshl_b32 s31, s52, 8
    s_add_u32 s31, s31, 200704
    v_lshl_add_u32 v21, v12, 5, s31
    v_and_b32 v22, 3, v1
    v_lshlrev_b32 v22, 6, v22
    v_lshl_add_u32 v22, v10, 4, v22
    v_bfe_u32 v23, v1, 2, 1
    v_lshl_add_u32 v22, v23, 1, v22
    v_add_u32 v22, v42, v22
    s_mov_b32 s47, 2000000
    s_waitcnt lgkmcnt(0)
    s_mul_i32 s36, s36, 0x9E3779B1
    s_add_u32 s36, s36, 0x7F4A7C15
    s_add_u32 s55, s55, 1
    s_mul_i32 s55, s55, 0x85EBCA6B
    s_xor_b32 s55, s55, s36
    s_mov_b32 s60, s55
    v_mov_b32 v124, s55
    v_mov_b32 v125, s36
    s_bfe_u32 s98, s55, 0x00080000
    s_bfe_u32 s99, s55, 0x00080008
    s_bfe_u32 s100, s55, 0x00080010
    s_bfe_u32 s101, s55, 0x00080018
L_ps0:
    ds_read_b128 v[44:47], v40 offset:58560
    s_waitcnt lgkmcnt(0)
    v_or3_b32 v44, v44, v45, v46
    v_or_b32 v44, v44, v47
    v_cmp_ne_u32 vcc, 0, v44
    s_cbranch_vccnz L_ps0
    global_load_dwordx4 v[152:155], v26, s[6:7] offset:128 nt
    global_load_dwordx4 v[156:159], v26, s[6:7] offset:192 nt
    global_load_dwordx4 v[160:163], v8, s[8:9] nt
    v_xor_b32 v27, 0x00000100, v8
    global_load_dwordx4 v[164:167], v27, s[8:9] nt
    v_xor_b32 v27, 0x00000200, v8
    global_load_dwordx4 v[168:171], v27, s[8:9] nt
    v_xor_b32 v27, 0x00000300, v8
    global_load_dwordx4 v[172:175], v27, s[8:9] nt
    ds_write_b32 v42, v40 offset:58576
L_ps1:
    ds_read_b128 v[44:47], v40 offset:58576
    s_waitcnt lgkmcnt(0)
    v_or3_b32 v44, v44, v45, v46
    v_or_b32 v44, v44, v47
    v_cmp_ne_u32 vcc, 0, v44
    s_cbranch_vccnz L_ps1
    global_load_dwordx4 v[28:31], v6, s[58:59] offset:-4096 sc1
    global_load_dwordx4 v[32:35], v6, s[58:59] sc1
    global_load_dword v36, v39, s[58:59] sc1
    v_xor_b32 v27, 0x00001000, v8
    global_load_dwordx4 v[176:179], v27, s[8:9] nt
    v_xor_b32 v27, 0x00001100, v8
    global_load_dwordx4 v[180:183], v27, s[8:9] nt
    v_xor_b32 v27, 0x00001200, v8
    global_load_dwordx4 v[184:187], v27, s[8:9] nt
    v_xor_b32 v27, 0x00001300, v8
    global_load_dwordx4 v[188:191], v27, s[8:9] nt
    ds_write_b32 v42, v40 offset:58624
L_ps2:
    ds_read_b128 v[44:47], v40 offset:58624
    s_waitcnt lgkmcnt(0)
    v_or3_b32 v44, v44, v45, v46
    v_or_b32 v44, v44, v47
    v_cmp_ne_u32 vcc, 0, v44
    s_cbranch_vccnz L_ps2
    global_load_dwordx4 v[112:115], v6, s[58:59] offset:-4096 sc1
    global_load_dwordx4 v[116:119], v6, s[58:59] sc1
    global_load_dword v120, v39, s[58:59] sc1
    ds_write_b32 v42, v40 offset:58544
    s_waitcnt vmcnt(12)
    v_perm_b32 v192, v164, v160, s42
    v_perm_b32 v196, v164, v160, s43
    v_perm_b32 v200, v165, v161, s42
    v_perm_b32 v204, v165, v161, s43
    v_perm_b32 v208, v166, v162, s42
    v_perm_b32 v212, v166, v162, s43
    v_perm_b32 v216, v167, v163, s42
    v_perm_b32 v220, v167, v163, s43
    s_waitcnt vmcnt(10)
    v_perm_b32 v193, v172, v168, s42
    v_perm_b32 v197, v172, v168, s43
    v_perm_b32 v201, v173, v169, s42
    v_perm_b32 v205, v173, v169, s43
    v_perm_b32 v209, v174, v170, s42
    v_perm_b32 v213, v174, v170, s43
    v_perm_b32 v217, v175, v171, s42
    v_perm_b32 v221, v175, v171, s43
    s_waitcnt vmcnt(7)
L_pq:
    v_xor_b32 v28, s98, v28
    v_xor_b32 v29, s99, v29
    v_xor_b32 v30, s100, v30
    v_xor_b32 v31, s101, v31
    v_xor_b32 v32, s98, v32
    v_xor_b32 v33, s99, v33
    v_xor_b32 v34, s100, v34
    v_xor_b32 v35, s101, v35
    v_or3_b32 v37, v28, v29, v30
    v_or3_b32 v37, v37, v31, v32
    v_or3_b32 v37, v37, v33, v34
    v_bitop3_b32 v37, v37, v35, s44 bitop3:0xa8
    v_xor_b32 v25, s60, v36
    v_or_b32 v37, v37, v25
    v_cmp_ne_u32 vcc, 0, v37
    s_cbranch_vccnz L_pq_retry
L_pq_ok:
    s_mov_b64 exec, -1
    v_pk_add_f32 v[28:29], v[28:29], v[32:33]
    v_pk_add_f32 v[30:31], v[30:31], v[34:35]
    s_nop 1
    v_permlane32_swap_b32 v28, v30
    v_permlane32_swap_b32 v29, v31
    v_pk_add_f32 v[28:29], v[28:29], v[30:31]
    v_cvt_pk_bf16_f32 v28, v28, v29
    ds_write_b32 v24, v28
    ds_write_b32 v42, v40 offset:58528
L_ps4:
    ds_read_b128 v[44:47], v40 offset:58528
    ds_read_b128 v[48:51], v14 offset:59392
    ds_read_b128 v[52:55], v14 offset:59456
    ds_read_b128 v[56:59], v14 offset:59520
    ds_read_b128 v[60:63], v14 offset:59584
    s_waitcnt lgkmcnt(4)
    v_or3_b32 v44, v44, v45, v46
    v_or_b32 v44, v44, v47
    v_cmp_ne_u32 vcc, 0, v44
    s_cbranch_vccnz L_ps4
    s_waitcnt lgkmcnt(3)
    v_mfma_f32_16x16x32_bf16 v[64:67], v[128:131], v[48:51], 0
    v_mfma_f32_16x16x32_bf16 v[68:71], v[144:147], v[48:51], 0
    s_waitcnt lgkmcnt(2)
    v_mfma_f32_16x16x32_bf16 v[64:67], v[132:135], v[52:55], v[64:67]
    v_mfma_f32_16x16x32_bf16 v[68:71], v[148:151], v[52:55], v[68:71]
    s_waitcnt lgkmcnt(1)
    v_mfma_f32_16x16x32_bf16 v[64:67], v[136:139], v[56:59], v[64:67]
    v_mfma_f32_16x16x32_bf16 v[68:71], v[152:155], v[56:59], v[68:71]
    s_waitcnt lgkmcnt(0)
    v_mfma_f32_16x16x32_bf16 v[64:67], v[140:143], v[60:63], v[64:67]
    v_mfma_f32_16x16x32_bf16 v[68:71], v[156:159], v[60:63], v[68:71]
    s_mov_b32 s47, 2000000
    s_nop 5
    v_cvt_pk_bf16_f32 v64, 0, v64
    v_cvt_pk_bf16_f32 v65, 0, v65
    v_cvt_pk_bf16_f32 v66, 0, v66
    v_cvt_pk_bf16_f32 v67, 0, v67
    v_cvt_pk_bf16_f32 v68, 0, v68
    v_cvt_pk_bf16_f32 v69, 0, v69
    v_cvt_pk_bf16_f32 v70, 0, v70
    v_cvt_pk_bf16_f32 v71, 0, v71
    v_pk_mul_f32 v[64:65], v[64:65], s[48:49] op_sel_hi:[1,0]
    v_pk_mul_f32 v[66:67], v[66:67], s[48:49] op_sel_hi:[1,0]
    v_pk_mul_f32 v[68:69], v[68:69], s[48:49] op_sel_hi:[1,0]
    v_pk_mul_f32 v[70:71], v[70:71], s[48:49] op_sel_hi:[1,0]
    v_cvt_pk_bf16_f32 v64, 0, v64
    v_cvt_pk_bf16_f32 v65, 0, v65
    v_cvt_pk_bf16_f32 v66, 0, v66
    v_cvt_pk_bf16_f32 v67, 0, v67
    v_cvt_pk_bf16_f32 v68, 0, v68
    v_cvt_pk_bf16_f32 v69, 0, v69
    v_cvt_pk_bf16_f32 v70, 0, v70
    v_cvt_pk_bf16_f32 v71, 0, v71
    v_max3_f32 v108, v64, v65, v66
    v_max3_f32 v109, v67, v68, v69
    v_max3_f32 v108, v108, v70, v71
    v_max_f32 v108, v108, v109
    v_mov_b32 v109, v108
    s_nop 1
    v_permlane16_swap_b32 v108, v109
    v_max_f32 v108, v108, v109
    v_mov_b32 v109, v108
    s_nop 1
    v_permlane32_swap_b32 v108, v109
    v_max_f32 v108, v108, v109
    v_mul_f32 v108, s49, v108
    v_pk_fma_f32 v[64:65], v[64:65], s[48:49], v[108:109] op_sel:[0,1,0] op_sel_hi:[1,1,0] neg_lo:[0,0,1] neg_hi:[0,0,1]
    v_pk_fma_f32 v[66:67], v[66:67], s[48:49], v[108:109] op_sel:[0,1,0] op_sel_hi:[1,1,0] neg_lo:[0,0,1] neg_hi:[0,0,1]
    v_pk_fma_f32 v[68:69], v[68:69], s[48:49], v[108:109] op_sel:[0,1,0] op_sel_hi:[1,1,0] neg_lo:[0,0,1] neg_hi:[0,0,1]
    v_pk_fma_f32 v[70:71], v[70:71], s[48:49], v[108:109] op_sel:[0,1,0] op_sel_hi:[1,1,0] neg_lo:[0,0,1] neg_hi:[0,0,1]
    v_exp_f32 v64, v64
    v_exp_f32 v65, v65
    v_exp_f32 v66, v66
    v_exp_f32 v67, v67
    v_exp_f32 v68, v68
    v_exp_f32 v69, v69
    v_exp_f32 v70, v70
    v_exp_f32 v71, v71
    v_min_u32 v108, -2, v108
    v_cvt_pk_bf16_f32 v64, v64, v65
    v_cvt_pk_bf16_f32 v65, v66, v67
    v_cvt_pk_bf16_f32 v66, v68, v69
    v_cvt_pk_bf16_f32 v67, v70, v71
    v_and_b32 v72, v64, v104
    v_and_b32 v73, v65, v104
    v_and_b32 v74, v66, v104
    v_and_b32 v75, v67, v104
    v_mfma_f32_16x16x32_bf16 v[100:103], v[96:99], v[64:67], 0
    v_and_b32 v76, v64, v105
    v_and_b32 v77, v65, v105
    v_and_b32 v78, v66, v105
    v_and_b32 v79, v67, v105
    v_and_b32 v80, v64, v106
    v_and_b32 v81, v65, v106
    v_and_b32 v82, v66, v106
    v_and_b32 v83, v67, v106
    v_and_b32 v84, v64, v107
    v_and_b32 v85, v65, v107
    v_and_b32 v86, v66, v107
    v_and_b32 v87, v67, v107
    s_waitcnt vmcnt(5)
    v_perm_b32 v194, v180, v176, s42
    v_perm_b32 v198, v180, v176, s43
    v_perm_b32 v202, v181, v177, s42
    v_perm_b32 v206, v181, v177, s43
    v_perm_b32 v210, v182, v178, s42
    v_perm_b32 v214, v182, v178, s43
    v_perm_b32 v218, v183, v179, s42
    v_perm_b32 v222, v183, v179, s43
    s_waitcnt vmcnt(3)
    v_perm_b32 v195, v188, v184, s42
    v_perm_b32 v199, v188, v184, s43
    v_perm_b32 v203, v189, v185, s42
    v_perm_b32 v207, v189, v185, s43
    v_perm_b32 v211, v190, v186, s42
    v_perm_b32 v215, v190, v186, s43
    v_perm_b32 v219, v191, v187, s42
    v_perm_b32 v223, v191, v187, s43
    s_nop 1
    v_mfma_f32_16x16x32_bf16 v[88:91], v[192:195], v[72:75], 0
    v_mfma_f32_16x16x32_bf16 v[92:95], v[208:211], v[72:75], 0
    v_mfma_f32_16x16x32_bf16 v[88:91], v[196:199], v[76:79], v[88:91]
    v_mfma_f32_16x16x32_bf16 v[92:95], v[212:215], v[76:79], v[92:95]
    v_mfma_f32_16x16x32_bf16 v[88:91], v[200:203], v[80:83], v[88:91]
    v_mfma_f32_16x16x32_bf16 v[92:95], v[216:219], v[80:83], v[92:95]
    v_mfma_f32_16x16x32_bf16 v[88:91], v[204:207], v[84:87], v[88:91]
    v_mfma_f32_16x16x32_bf16 v[92:95], v[220:223], v[84:87], v[92:95]
    s_mov_b64 exec, 0xf
    ds_write_b32 v16, v100 offset:58432
    s_mov_b64 exec, -1
    s_nop 3
    ds_write_b128 v15, v[88:91] offset:0
    ds_write_b128 v15, v[92:95] offset:1088
    s_mov_b64 exec, 0xf
    ds_write_b32 v16, v108 offset:58368
    s_mov_b64 exec, -1
    s_cmp_ge_u32 s3, 2
    s_cbranch_scc1 L_nocomb
L_cmb:
    ds_read_b128 v[64:67], v18 offset:58368
    ds_read_b128 v[68:71], v18 offset:58432
    ds_read_b128 v[72:75], v17 offset:0
    ds_read_b128 v[76:79], v17 offset:2176
    ds_read_b128 v[80:83], v17 offset:4352
    ds_read_b128 v[84:87], v17 offset:6528
    s_waitcnt lgkmcnt(5)
    v_max3_u32 v110, v64, v65, v66
    v_max3_f32 v108, v64, v65, v66
    v_max_u32 v110, v110, v67
    v_max_f32 v108, v108, v67
    v_cmp_eq_u32 vcc, -1, v110
    s_cbranch_vccnz L_cmb
    v_pk_add_f32 v[64:65], v[64:65], v[108:109] op_sel_hi:[1,0] neg_lo:[0,1] neg_hi:[0,1]
    v_pk_add_f32 v[66:67], v[66:67], v[108:109] op_sel_hi:[1,0] neg_lo:[0,1] neg_hi:[0,1]
    v_exp_f32 v64, v64
    v_exp_f32 v65, v65
    v_exp_f32 v66, v66
    v_exp_f32 v67, v67
    s_waitcnt lgkmcnt(4)
    v_pk_mul_f32 v[68:69], v[64:65], v[68:69]
    v_pk_fma_f32 v[68:69], v[66:67], v[70:71], v[68:69]
    v_add_f32 v110, v68, v69
    v_rcp_f32 v111, v110
    v_log_f32 v110, v110
    s_waitcnt lgkmcnt(0)
    v_pk_mul_f32 v[88:89], v[72:73], v[64:65] op_sel:[0,0] op_sel_hi:[1,0]
    v_pk_mul_f32 v[90:91], v[74:75], v[64:65] op_sel:[0,0] op_sel_hi:[1,0]
    v_add_f32 v108, v108, v110
    v_mov_b32 v109, v124
    v_pk_fma_f32 v[88:89], v[76:77], v[64:65], v[88:89] op_sel:[0,1,0] op_sel_hi:[1,1,1]
    v_pk_fma_f32 v[90:91], v[78:79], v[64:65], v[90:91] op_sel:[0,1,0] op_sel_hi:[1,1,1]
    v_pk_fma_f32 v[88:89], v[80:81], v[66:67], v[88:89] op_sel:[0,0,0] op_sel_hi:[1,0,1]
    v_pk_fma_f32 v[90:91], v[82:83], v[66:67], v[90:91] op_sel:[0,0,0] op_sel_hi:[1,0,1]
    v_pk_fma_f32 v[88:89], v[84:85], v[66:67], v[88:89] op_sel:[0,1,0] op_sel_hi:[1,1,1]
    v_pk_fma_f32 v[90:91], v[86:87], v[66:67], v[90:91] op_sel:[0,1,0] op_sel_hi:[1,1,1]
    v_pk_mul_f32 v[88:89], v[88:89], v[110:111] op_sel:[0,1] op_sel_hi:[1,1]
    v_pk_mul_f32 v[90:91], v[90:91], v[110:111] op_sel:[0,1] op_sel_hi:[1,1]
    v_perm_b32 v88, v88, v124, s38
    v_perm_b32 v89, v89, v124, s39
    v_perm_b32 v90, v90, v124, s40
    v_perm_b32 v91, v91, v124, s41
    global_store_dwordx4 v19, v[88:91], s[26:27]
    s_mov_b32 exec_lo, 0x00010001
    s_mov_b32 exec_hi, 0x00010001
    global_store_dwordx2 v20, v[108:109], s[26:27]
    s_mov_b64 exec, -1
    s_cmp_lg_u32 s54, 0
    s_cbranch_scc1 L_fbO
L_nocomb:
    ds_write_b32 v42, v40 offset:58656
L_ps5:
    ds_read_b128 v[44:47], v40 offset:58640
    s_waitcnt lgkmcnt(0)
    v_or3_b32 v44, v44, v45, v46
    v_or_b32 v44, v44, v47
    v_cmp_ne_u32 vcc, 0, v44
    s_cbranch_vccnz L_ps5
L_po:
    global_load_dwordx4 v[48:51], v21, s[58:59] offset:0 sc1
    global_load_dwordx4 v[52:55], v21, s[58:59] offset:16 sc1
    global_load_dwordx4 v[56:59], v43, s[58:59] offset:-4096 sc1
    global_load_dwordx4 v[60:63], v43, s[58:59] offset:-2048 sc1
    global_load_dwordx4 v[64:67], v43, s[58:59] offset:0 sc1
    global_load_dwordx4 v[68:71], v43, s[58:59] offset:2048 sc1
    s_mov_b64 exec, -1
    s_waitcnt vmcnt(4)
    v_xor_b32 v76, s60, v49
    v_xor_b32 v77, s60, v51
    v_xor_b32 v78, s60, v53
    v_or3_b32 v76, v76, v77, v78
    v_xor_b32 v77, s60, v55
    v_or_b32 v76, v76, v77
    v_cmp_ne_u32 vcc, 0, v76
    s_cbranch_vccnz L_po_retry
L_po_ok:
    v_max3_f32 v76, v48, v50, v52
    v_max_f32 v76, v76, v54
    s_nop 1
    v_max_f32_dpp v76, v76, v76 row_ror:8 row_mask:0xf bank_mask:0xf
    v_mov_b32 v77, v76
    s_nop 1
    v_permlane16_swap_b32 v76, v77
    v_max_f32 v76, v76, v77
    v_mov_b32 v77, v76
    s_nop 1
    v_permlane32_swap_b32 v76, v77
    v_max_f32 v76, v76, v77
    v_sub_f32 v80, v48, v76
    v_sub_f32 v81, v50, v76
    v_sub_f32 v82, v52, v76
    v_sub_f32 v83, v54, v76
    v_exp_f32 v80, v80
    v_exp_f32 v81, v81
    v_exp_f32 v82, v82
    v_exp_f32 v83, v83
    s_nop 0
    v_pk_add_f32 v[84:85], v[80:81], v[82:83]
    v_add_f32 v84, v84, v85
    v_mov_b32 v85, v84
    s_nop 1
    v_permlane32_swap_b32 v84, v85
    v_add_f32 v84, v84, v85
    v_mov_b32 v85, v84
    s_nop 1
    v_permlane16_swap_b32 v84, v85
    v_add_f32 v84, v84, v85
L_pd:
    s_waitcnt vmcnt(0)
    v_xor_b32 v56, s98, v56
    v_xor_b32 v57, s99, v57
    v_xor_b32 v58, s100, v58
    v_xor_b32 v59, s101, v59
    v_xor_b32 v60, s98, v60
    v_xor_b32 v61, s99, v61
    v_xor_b32 v62, s100, v62
    v_xor_b32 v63, s101, v63
    v_xor_b32 v64, s98, v64
    v_xor_b32 v65, s99, v65
    v_xor_b32 v66, s100, v66
    v_xor_b32 v67, s101, v67
    v_xor_b32 v68, s98, v68
    v_xor_b32 v69, s99, v69
    v_xor_b32 v70, s100, v70
    v_xor_b32 v71, s101, v71
    v_or3_b32 v79, v56, v57, v58
    v_or3_b32 v76, v59, v60, v61
    v_or3_b32 v79, v79, v62, v63
    v_or3_b32 v76, v76, v64, v65
    v_or3_b32 v79, v79, v66, v67
    v_or3_b32 v76, v76, v68, v69
    v_or3_b32 v79, v79, v70, v71
    v_bitop3_b32 v79, v79, v76, s44 bitop3:0xa8
    v_cmp_ne_u32 vcc, 0, v79
    s_cbranch_vccnz L_pd_retry
L_pd_ok:
    s_mov_b64 exec, -1
    v_add_f32_dpp v84, v84, v84 row_ror:8 row_mask:0xf bank_mask:0xf
    v_pk_mul_f32 v[56:57], v[56:57], v[80:81] op_sel:[0,0] op_sel_hi:[1,0]
    v_pk_mul_f32 v[58:59], v[58:59], v[80:81] op_sel:[0,0] op_sel_hi:[1,0]
    v_rcp_f32 v84, v84
    v_pk_fma_f32 v[56:57], v[60:61], v[80:81], v[56:57] op_sel:[0,1,0] op_sel_hi:[1,1,1]
    v_pk_fma_f32 v[58:59], v[62:63], v[80:81], v[58:59] op_sel:[0,1,0] op_sel_hi:[1,1,1]
    v_pk_fma_f32 v[56:57], v[64:65], v[82:83], v[56:57] op_sel:[0,0,0] op_sel_hi:[1,0,1]
    v_pk_fma_f32 v[58:59], v[66:67], v[82:83], v[58:59] op_sel:[0,0,0] op_sel_hi:[1,0,1]
    v_pk_fma_f32 v[56:57], v[68:69], v[82:83], v[56:57] op_sel:[0,1,0] op_sel_hi:[1,1,1]
    v_pk_fma_f32 v[58:59], v[70:71], v[82:83], v[58:59] op_sel:[0,1,0] op_sel_hi:[1,1,1]
    s_nop 1
    v_permlane32_swap_b32 v56, v58
    v_permlane32_swap_b32 v57, v59
    v_pk_add_f32 v[56:57], v[56:57], v[58:59]
    s_nop 1
    v_permlane16_swap_b32 v56, v57
    v_add_f32 v56, v56, v57
    s_nop 1
    v_add_f32_dpp v56, v56, v56 row_ror:8 row_mask:0xf bank_mask:0xf
    v_mul_f32 v56, v56, v84
    v_cvt_pk_bf16_f32 v56, v56, v56
    ds_write_b16 v22, v56 offset:58688
    ds_write_b32 v42, v40 offset:58608
    s_endpgm
L_noffn:
    s_setprio 0
L_ps12:
    ds_read_b128 v[44:47], v40 offset:58544
    s_waitcnt lgkmcnt(0)
    v_or3_b32 v44, v44, v45, v46
    v_or_b32 v44, v44, v47
    v_cmp_ne_u32 vcc, 0, v44
    s_cbranch_vccnz L_ps12
L_ps13:
    ds_read_b128 v[44:47], v40 offset:58656
    s_waitcnt lgkmcnt(0)
    v_or3_b32 v44, v44, v45, v46
    v_or_b32 v44, v44, v47
    v_cmp_ne_u32 vcc, 0, v44
    s_cbranch_vccnz L_ps13
    s_add_u32 m0, s46, 32768
    s_nop 0
    global_load_lds_dwordx4 v36, s[12:13] nt
    v_xor_b32 v36, 0x00002040, v36
    s_add_u32 m0, s46, 33792
    s_nop 0
    global_load_lds_dwordx4 v36, s[12:13] nt
    v_xor_b32 v36, 0x00006040, v36
    s_add_u32 m0, s46, 34816
    s_nop 0
    global_load_lds_dwordx4 v36, s[12:13] nt
    v_xor_b32 v36, 0x00002040, v36
    s_add_u32 m0, s46, 35840
    s_nop 0
    global_load_lds_dwordx4 v36, s[12:13] nt
    s_waitcnt vmcnt(0)
    ds_write_b32 v42, v40 offset:58640
    v_mov_b32 v88, 0
    v_mov_b32 v89, 0
    v_mov_b32 v90, 0
    v_mov_b32 v91, 0
    s_waitcnt vmcnt(0)
    ds_write_b32 v42, v40 offset:58592
L_ps14:
    ds_read_b128 v[44:47], v40 offset:58592
    ds_read_b64_tr_b16 v[64:65], v3 offset:32768
    ds_read_b64_tr_b16 v[66:67], v3 offset:33280
    ds_read_b64_tr_b16 v[68:69], v3 offset:36864
    ds_read_b64_tr_b16 v[70:71], v3 offset:37376
    ds_read_b64_tr_b16 v[72:73], v3 offset:40960
    ds_read_b64_tr_b16 v[74:75], v3 offset:41472
    ds_read_b64_tr_b16 v[76:77], v3 offset:45056
    ds_read_b64_tr_b16 v[78:79], v3 offset:45568
    s_waitcnt lgkmcnt(8)
    v_or3_b32 v44, v44, v45, v46
    v_or_b32 v44, v44, v47
    v_cmp_ne_u32 vcc, 0, v44
    s_cbranch_vccnz L_ps14
    s_branch L_final
L_pq_retry:
    s_sub_u32 s47, s47, 1
    s_cbranch_scc1 L_pq_ok
    s_cmp_lg_u32 s47, 1999999
    s_cbranch_scc1 L_pq_r2
    s_waitcnt vmcnt(0)
    v_mov_b32 v28, v112
    v_mov_b32 v29, v113
    v_mov_b32 v30, v114
    v_mov_b32 v31, v115
    v_mov_b32 v32, v116
    v_mov_b32 v33, v117
    v_mov_b32 v34, v118
    v_mov_b32 v35, v119
    v_mov_b32 v36, v120
    s_branch L_pq
L_pq_r2:
    s_cmp_lg_u32 s47, 1999744
    s_cbranch_scc1 L_pq_nf
    s_mov_b32 s54, 1
    s_mov_b64 exec, -1
    s_mov_b64 s[50:51], vcc
L_ps3:
    ds_read_b128 v[44:47], v40 offset:58560
    ds_read_b128 v[64:67], v41 offset:59072
    s_waitcnt lgkmcnt(0)
    v_or3_b32 v44, v44, v45, v46
    v_or_b32 v44, v44, v47
    v_cmp_ne_u32 vcc, 0, v44
    s_cbranch_vccnz L_ps3
    s_mov_b64 vcc, s[50:51]
    s_mov_b32 exec_lo, 0x00010001
    s_mov_b32 exec_hi, 0x00010001
    v_perm_b32 v64, v64, v125, s38
    v_perm_b32 v65, v65, v125, s39
    v_perm_b32 v66, v66, v125, s40
    v_perm_b32 v67, v67, v125, s41
    global_store_dword v38, v125, s[56:57] sc1
    global_store_dwordx4 v5, v[64:67], s[56:57] sc1
L_pq_nf:
    s_mov_b64 exec, vcc
    s_and_b32 s31, s47, s54
    s_cselect_b64 s[58:59], s[56:57], s[26:27]
    s_cselect_b32 s60, s36, s55
    s_bfe_u32 s98, s60, 0x00080000
    s_bfe_u32 s99, s60, 0x00080008
    s_bfe_u32 s100, s60, 0x00080010
    s_bfe_u32 s101, s60, 0x00080018
    global_load_dwordx4 v[28:31], v6, s[58:59] offset:-4096 sc1
    global_load_dwordx4 v[32:35], v6, s[58:59] sc1
    global_load_dword v36, v39, s[58:59] sc1
    s_waitcnt vmcnt(0)
    s_branch L_pq
L_fbO:
    v_perm_b32 v88, v88, v125, s38
    v_perm_b32 v89, v89, v125, s39
    v_perm_b32 v90, v90, v125, s40
    v_perm_b32 v91, v91, v125, s41
    v_mov_b32 v109, v125
    global_store_dwordx4 v19, v[88:91], s[56:57] sc1
    s_mov_b32 exec_lo, 0x00010001
    s_mov_b32 exec_hi, 0x00010001
    global_store_dwordx2 v20, v[108:109], s[56:57] sc1
    s_mov_b64 exec, -1
    s_branch L_nocomb
L_po_retry:
    s_sub_u32 s47, s47, 1
    s_cbranch_scc1 L_po_giveup
    s_cmp_lg_u32 s54, 0
    s_cbranch_scc1 L_po_fb
    s_mov_b64 exec, vcc
    global_load_dwordx4 v[48:51], v21, s[58:59] offset:0 sc1
    global_load_dwordx4 v[52:55], v21, s[58:59] offset:16 sc1
    s_waitcnt vmcnt(0)
    v_xor_b32 v76, s60, v49
    v_xor_b32 v77, s60, v51
    v_xor_b32 v78, s60, v53
    v_or3_b32 v76, v76, v77, v78
    v_xor_b32 v77, s60, v55
    v_or_b32 v76, v76, v77
    v_cmp_ne_u32 vcc, 0, v76
    s_andn2_b64 exec, exec, vcc
    s_cbranch_execz L_po_retry
    global_load_dwordx4 v[56:59], v43, s[58:59] offset:-4096 sc1
    global_load_dwordx4 v[60:63], v43, s[58:59] offset:-2048 sc1
    global_load_dwordx4 v[64:67], v43, s[58:59] offset:0 sc1
    global_load_dwordx4 v[68:71], v43, s[58:59] offset:2048 sc1
    s_cbranch_vccnz L_po_retry
L_po_giveup:
    s_mov_b64 exec, -1
    s_branch L_po_ok
L_po_fb:
    s_and_b32 s31, s47, s54
    s_cselect_b64 s[58:59], s[56:57], s[26:27]
    s_cselect_b32 s60, s36, s55
    s_bfe_u32 s98, s60, 0x00080000
    s_bfe_u32 s99, s60, 0x00080008
    s_bfe_u32 s100, s60, 0x00080010
    s_bfe_u32 s101, s60, 0x00080018
    s_branch L_po
L_pd_retry:
    s_sub_u32 s47, s47, 1
    s_cbranch_scc1 L_pd_ok
    s_mov_b64 exec, vcc
    global_load_dwordx4 v[56:59], v43, s[58:59] offset:-4096 sc1
    global_load_dwordx4 v[60:63], v43, s[58:59] offset:-2048 sc1
    global_load_dwordx4 v[64:67], v43, s[58:59] offset:0 sc1
    global_load_dwordx4 v[68:71], v43, s[58:59] offset:2048 sc1
    s_branch L_pd
L_pg_retry:
    s_sub_u32 s47, s47, 1
    s_cbranch_scc1 L_pg_ok
    s_cmp_lg_u32 s47, 1999744
    s_cbranch_scc1 L_pg_nf
    s_mov_b32 s54, 1
    s_mov_b32 exec_lo, 0x00030003
    s_mov_b32 exec_hi, 0x00030003
    v_perm_b32 v88, v88, v125, s38
    v_perm_b32 v89, v89, v125, s39
    v_perm_b32 v90, v90, v125, s40
    v_perm_b32 v91, v91, v125, s41
    global_store_dwordx4 v18, v[88:91], s[56:57] sc1
L_pg_nf:
    s_mov_b64 exec, vcc
    s_and_b32 s31, s47, s54
    s_cselect_b64 s[58:59], s[56:57], s[26:27]
    s_cselect_b32 s60, s36, s55
    s_bfe_u32 s98, s60, 0x00080000
    s_bfe_u32 s99, s60, 0x00080008
    s_bfe_u32 s100, s60, 0x00080010
    s_bfe_u32 s101, s60, 0x00080018
    s_branch L_pg
L_end:
    s_endpgm
.section .rodata,"a"
.p2align 6
.amdhsa_kernel parallel_sum__sliding_block_cached__geglu_ffn__decode_kernel
  .amdhsa_next_free_vgpr 224
  .amdhsa_next_free_sgpr 102
  .amdhsa_accum_offset 224
  .amdhsa_group_segment_fixed_size 0
  .amdhsa_kernarg_size 96
  .amdhsa_user_sgpr_count 2
  .amdhsa_user_sgpr_kernarg_segment_ptr 1
  .amdhsa_system_sgpr_workgroup_id_x 1
  .amdhsa_float_denorm_mode_32 3
.end_amdhsa_kernel
```
